```python
import torch

def _softmax(x, axis=-1):
    return torch.softmax(x, dim=axis)
def _gelu(x):
    return torch.nn.functional.gelu(x, approximate="tanh")
def _silu(x):
    return torch.nn.functional.silu(x)
def _sigmoid(x):
    return torch.sigmoid(x)
def _layernorm(x, axis=-1, eps=1e-5):
    m = x.mean(dim=axis, keepdim=True)
    v = x.var(dim=axis, keepdim=True, unbiased=False)
    return (x - m) / torch.sqrt(v + eps)
def _scatter_add(tgt, idx, src, axis=0):
    return tgt.clone().index_add_(axis, idx, src)
def _segment_sum(src, seg, n):
    out = torch.zeros((n,) + src.shape[1:], dtype=src.dtype)
    return out.index_add_(0, seg, src)
def _pad(x, pw):
    flat = tuple(v for pair in reversed(pw) for v in pair)
    return torch.nn.functional.pad(x, flat)

kernel_name = 'standalone__sequential_behavior_din__recsys'

def setup_inputs():

    _w = (lambda a: (lambda t: t.to(torch.bfloat16) if t.is_floating_point() else t)(torch.as_tensor(a)))
    B, L, D = 16384, 200, 16
    H = D
    return {
        "target": _w((lambda *s: torch.randn(*s, dtype=torch.bfloat16) * 1.6)(B, D)),
        "hist": _w((lambda *s: torch.randn(*s, dtype=torch.bfloat16) * 1.6)(B, L, D)),
        "mask": _w((lambda lo, hi, *s: torch.randint(lo, hi, s))(0, 2, B, L).to(float)),
        "w1": _w((lambda *s: torch.randn(*s, dtype=torch.bfloat16) * 1.6)(4 * D, H) * (4 * D) ** -0.5),
        "b1": _w((lambda *s: torch.randn(*s, dtype=torch.bfloat16) * 1.6)(H) * 0.1),
        "w2": _w((lambda *s: torch.randn(*s, dtype=torch.bfloat16) * 0.05)(H, 1) * H ** -0.5),
        "b2": _w((lambda *s: torch.randn(*s, dtype=torch.bfloat16) * 0.05)(1) * 0.1),
    }

def reference(target, hist, mask, w1, b1, w2, b2):
    L = hist.shape[1]
    tgt = (lambda x, n, axis: torch.repeat_interleave(x, n, dim=axis))(target[:, None, :], L, axis=1)
    feat = torch.concatenate([hist, tgt, hist - tgt, hist * tgt], axis=-1)
    h = _sigmoid(feat @ w1 + b1)
    scores = (h @ w2 + b2)[..., 0] * mask
    return torch.einsum('bl,bld->bd', scores, hist)
```

```asm
; @launch grid=(512,1,1) block=(256,1,1) lds=35840
.amdgcn_target "amdgcn-amd-amdhsa--gfx950"
.text
.globl standalone__sequential_behavior_din__recsys_kernel
.p2align 8
.type standalone__sequential_behavior_din__recsys_kernel,@function
standalone__sequential_behavior_din__recsys_kernel:
    s_load_dwordx16 s[4:19], s[0:1], 0
    s_cmpk_ge_u32 s2, 512
    s_cbranch_scc1 L_end
    s_setprio 3
    v_lshrrev_b32 v7, 6, v0
    v_and_b32 v0, 63, v0
    v_readfirstlane_b32 s61, v7
    v_and_b32 v28, 31, v0
    v_lshrrev_b32 v29, 5, v0
    v_cmp_gt_u32 vcc, 25, v28
    v_mul_u32_u24 v31, 25, v29
    v_add_u32 v33, v31, v28
    s_bitcmp1_b32 s2, 8
    s_cselect_b32 s62, s61, 7
    s_cmp_eq_u32 s62, 0
    s_cbranch_scc1 L_pad0
    s_cmp_eq_u32 s62, 1
    s_cbranch_scc1 L_pad1
    s_cmp_eq_u32 s62, 2
    s_cbranch_scc1 L_pad2
    s_cmp_eq_u32 s62, 3
    s_cbranch_scc1 L_pad3
L_back:
    v_lshlrev_b32 v34, 4, v33
    v_lshlrev_b32 v1, 4, v29
    v_cndmask_b32 v34, 2.0, v34, vcc
    s_and_b32 s3, s2, 7
    s_lshr_b32 s2, s2, 3
    s_lshl_b32 s3, s3, 6
    s_or_b32 s2, s2, s3
    s_lshl2_add_u32 s3, s2, s61
    s_mul_i32 s21, s3, 800
    s_lshl_b32 s20, s21, 4
    s_lshl_b32 s22, s3, 6
    s_mov_b32 s56, 1638400
    s_lshl_b32 s57, s56, 1
    s_add_u32 s58, s57, s56
    s_mov_b32 s79, 0x20000
    s_mov_b32 s27, s79
    s_movk_i32 s26, 12800
    s_mov_b32 s31, s79
    s_add_u32 s30, s58, 800
    v_lshrrev_b32 v31, 1, v28
    v_xor_b32 v31, v31, v28
    v_and_b32 v31, 4, v31
    v_mul_u32_u24 v31, 3, v31
    v_xor_b32 v30, v31, v28
    v_lshl_add_u32 v21, v30, 5, v1
    v_and_b32 v31, 16, v28
    v_lshl_add_u32 v20, v31, 6, v21
    v_mul_u32_u24 v31, 0x10020, v28
    v_and_b32 v31, 0x60020, v31
    v_or_b32 v22, v31, v1
    v_lshrrev_b32 v31, 2, v0
    v_xor_b32 v31, v31, v0
    v_and_b32 v31, 4, v31
    v_lshl_add_u32 v35, v31, 8, v1
    v_mov_b32 v12, 0
    v_lshl_add_u32 v101, v28, 5, v1
    v_mul_u32_u24 v33, 0x80008, v33
    s_mov_b32 s62, 0x20002
    v_add_u32 v112, 0x10000, v33
    v_add_u32 v113, s62, v112
    v_add_u32 v114, s62, v113
    v_add_u32 v115, s62, v114
    s_waitcnt lgkmcnt(0)
    s_add_u32 s28, s8, s21
    s_addc_u32 s29, s9, 0
    buffer_load_dwordx4 v[148:151], v34, s[28:31], 0 offen nt
    s_add_u32 s24, s6, s20
    s_addc_u32 s25, s7, 0
    buffer_load_dwordx4 v[144:147], v101, s[24:27], 0 offen nt
    s_mov_b64 s[76:77], s[10:11]
    s_movk_i32 s78, 2048
    buffer_load_dwordx4 v[52:55], v20, s[76:79], 0 offen
    buffer_load_dwordx4 v[56:59], v21, s[76:79], 0 offen offset:512
    s_add_u32 s76, s4, s22
    s_addc_u32 s77, s5, 0
    s_mov_b32 s78, 393280
    buffer_load_dwordx4 v[60:63], v22, s[76:79], 0 offen
    s_mov_b64 s[76:77], s[12:13]
    s_mov_b32 s78, 32
    buffer_load_dwordx4 v[64:67], v1, s[76:79], 0 offen
    s_mov_b64 s[76:77], s[14:15]
    buffer_load_dwordx4 v[8:11], v35, s[76:79], 0 offen
    s_mov_b64 s[76:77], s[16:17]
    s_mov_b32 s78, 2
    buffer_load_short_d16_hi v12, off, s[76:79], 0
    buffer_load_dwordx4 v[152:155], v34, s[28:31], s56 offen nt
    buffer_load_dwordx4 v[156:159], v34, s[28:31], s57 offen nt
    buffer_load_dwordx4 v[160:163], v34, s[28:31], s58 offen nt
    s_mul_i32 s82, s61, 8960
    v_lshlrev_b32 v117, 2, v28
    v_cmp_gt_u32 vcc, 4, v0
    v_mov_b32 v135, 0x10000
    v_mov_b32 v118, 0xffff
    v_mov_b32 v102, 0
    v_add_u32 v2, s82, v117
    v_cndmask_b32 v135, v135, 0, vcc
    s_mov_b32 s86, 0x05040100
    s_mov_b32 s87, 0x07060302
    s_mov_b64 s[66:67], 0
    s_mov_b64 s[54:55], 0
    s_mov_b32 s81, -1
    s_sub_u32 s51, s82, 128
    s_mov_b32 s83, 0
    s_waitcnt vmcnt(10)
    s_branch L_bldA1
L_pad0:
    s_branch L_back
L_bld:
    s_set_gpr_idx_on s83, gpr_idx(SRC0)
    v_perm_b32 v104, v148, v112, s86
    v_perm_b32 v105, v148, v112, s87
    v_perm_b32 v106, v149, v113, s86
    v_perm_b32 v107, v149, v113, s87
    v_perm_b32 v108, v150, v114, s86
    v_perm_b32 v109, v150, v114, s87
    v_perm_b32 v110, v151, v115, s86
    v_perm_b32 v111, v151, v115, s87
    s_set_gpr_idx_off
    v_cmp_le_u32 s[32:33], v135, v104
    v_cmp_le_u32 s[34:35], v135, v105
    v_cmp_le_u32 s[36:37], v135, v106
    v_cmp_le_u32 s[38:39], v135, v107
    v_cmp_le_u32 s[40:41], v135, v108
    v_cmp_le_u32 s[42:43], v135, v109
    v_cmp_le_u32 s[44:45], v135, v110
    v_cmp_le_u32 s[46:47], v135, v111
    v_mbcnt_lo_u32_b32 v103, s32, 0
    v_mbcnt_hi_u32_b32 v103, s33, v103
    v_mbcnt_lo_u32_b32 v103, s34, v103
    v_mbcnt_hi_u32_b32 v103, s35, v103
    v_mbcnt_lo_u32_b32 v103, s36, v103
    v_mbcnt_hi_u32_b32 v103, s37, v103
    v_mbcnt_lo_u32_b32 v103, s38, v103
    v_mbcnt_hi_u32_b32 v103, s39, v103
    v_mbcnt_lo_u32_b32 v103, s40, v103
    v_mbcnt_hi_u32_b32 v103, s41, v103
    v_mbcnt_lo_u32_b32 v103, s42, v103
    v_mbcnt_hi_u32_b32 v103, s43, v103
    v_mbcnt_lo_u32_b32 v103, s44, v103
    v_mbcnt_hi_u32_b32 v103, s45, v103
    v_mbcnt_lo_u32_b32 v103, s46, v103
    v_mbcnt_hi_u32_b32 v103, s47, v103
    v_lshl_add_u32 v116, v103, 2, s82
    v_readlane_b32 s48, v103, 31
    v_readlane_b32 s49, v103, 63
    v_mov_b32 v135, 0x10000
    s_add_u32 s83, s83, 4
    s_nop 0
    s_add_u32 s62, s48, 31
    s_sub_u32 s49, s49, s48
    s_lshr_b32 s62, s62, 5
    s_max_u32 s62, s62, 1
    s_add_u32 s81, s81, s62
    s_bitset1_b64 s[66:67], s81
    s_lshl_b32 s62, s62, 7
    s_add_u32 s51, s51, s62
    v_add_u32 v119, s51, v117
    s_lshl_b32 s48, s48, 2
    s_sub_u32 s48, s62, s48
    s_add_u32 s49, s49, 31
    s_lshr_b32 s49, s49, 5
    s_max_u32 s49, s49, 1
    s_add_u32 s81, s81, s49
    s_lshl_b32 s49, s49, 7
    s_add_u32 s51, s51, s49
    s_mov_b32 exec_lo, 0
    v_add_u32 v116, s48, v116
    v_add_u32 v119, s51, v117
    s_mov_b32 exec_lo, -1
    ds_write_b32 v119, v118
    s_mov_b64 exec, s[32:33]
    ds_write_b32 v116, v104
    v_add_u32 v116, 4, v116
    s_mov_b64 exec, s[34:35]
    ds_write_b32 v116, v105
    v_add_u32 v116, 4, v116
    s_mov_b64 exec, s[36:37]
    ds_write_b32 v116, v106
    v_add_u32 v116, 4, v116
    s_mov_b64 exec, s[38:39]
    ds_write_b32 v116, v107
    v_add_u32 v116, 4, v116
    s_mov_b64 exec, s[40:41]
    ds_write_b32 v116, v108
    v_add_u32 v116, 4, v116
    s_mov_b64 exec, s[42:43]
    ds_write_b32 v116, v109
    v_add_u32 v116, 4, v116
    s_mov_b64 exec, s[44:45]
    ds_write_b32 v116, v110
    v_add_u32 v116, 4, v116
    s_mov_b64 exec, s[46:47]
    ds_write_b32 v116, v111
    s_mov_b64 exec, -1
    s_bitset1_b64 s[66:67], s81
    s_add_u32 s82, s51, 128
    s_sub_u32 s62, s81, 2
    s_bitset1_b64 s[54:55], s62
    s_sub_u32 s62, s62, 3
    s_cmp_lt_u32 s83, 16
    s_cselect_b32 s50, s62, 64
    s_cbranch_scc1 L_bldR
    v_lshl_add_u32 v119, v0, 2, s82
    ds_write_b32 v119, v118 offset:0
    ds_write_b32 v119, v118 offset:256
L_bldR:
    s_setpc_b64 s[70:71]
L_bldA:
    s_waitcnt vmcnt(0)
L_bldA1:
    s_call_b64 s[70:71], L_bld
    s_cmp_lt_i32 s50, -2
    s_cbranch_scc1 L_bldA
    ds_read_u16 v93, v2 offset:128
    ds_read_u16 v94, v2 offset:256
    ds_read_u16 v100, v2 offset:384
    ds_read_u16_d16_hi v102, v2 offset:2
    s_waitcnt lgkmcnt(3)
    v_lshl_add_u32 v93, v93, 5, v1
    buffer_load_dwordx4 v[140:143], v93, s[24:27], 0 offen nt
    s_bitcmp1_b64 s[54:55], 63
    s_cselect_b32 s62, 26214400, 0
    s_add_u32 s24, s24, s62
    s_addc_u32 s25, s25, 0
    s_waitcnt lgkmcnt(2)
    v_lshl_add_u32 v94, v94, 5, v1
    buffer_load_dwordx4 v[136:139], v94, s[24:27], 0 offen nt
    s_setprio 1
    v_lshlrev_b32 v31, 3, v29
    v_sub_u32 v31, v30, v31
    v_and_b32 v32, 1, v31
    v_lshlrev_b32 v32, 4, v32
    v_mov_b32 v33, 0x3f80
    v_lshlrev_b32 v32, v32, v33
    v_lshrrev_b32 v31, 1, v31
    v_cmp_eq_u32 s[32:33], 0, v31
    v_cmp_eq_u32 s[34:35], 1, v31
    v_cmp_eq_u32 s[36:37], 2, v31
    v_cmp_eq_u32 s[38:39], 3, v31
    v_mov_b32 v31, 0xbf317218
    s_mov_b32 s68, 0x10000
    s_mov_b32 s69, 0x1000000
    v_cndmask_b32 v36, 0, v31, s[68:69]
    s_lshl_b64 s[68:69], s[68:69], 1
    v_cndmask_b32 v37, 0, v31, s[68:69]
    s_lshl_b64 s[68:69], s[68:69], 1
    v_cndmask_b32 v38, 0, v31, s[68:69]
    s_lshl_b64 s[68:69], s[68:69], 1
    v_cndmask_b32 v39, 0, v31, s[68:69]
    s_lshl_b64 s[68:69], s[68:69], 1
    v_cndmask_b32 v40, 0, v31, s[68:69]
    s_lshl_b64 s[68:69], s[68:69], 1
    v_cndmask_b32 v41, 0, v31, s[68:69]
    s_lshl_b64 s[68:69], s[68:69], 1
    v_cndmask_b32 v42, 0, v31, s[68:69]
    s_lshl_b64 s[68:69], s[68:69], 1
    v_cndmask_b32 v43, 0, v31, s[68:69]
    v_mov_b64 v[44:45], 0
    v_mov_b64 v[46:47], 0
    v_mov_b64 v[48:49], 0
    v_mov_b64 v[50:51], 0
    v_cndmask_b32 v16, 0, v32, s[32:33]
    v_cndmask_b32 v17, 0, v32, s[34:35]
    v_cndmask_b32 v18, 0, v32, s[36:37]
    v_cndmask_b32 v19, 0, v32, s[38:39]
    s_branch L_over1
L_pad1:
    s_branch L_back
L_over1:
    s_mul_i32 s62, s61, 8960
    s_add_u32 s62, s62, 7680
    v_lshl_add_u32 v5, v29, 5, s62
    v_and_b32 v31, 7, v28
    v_lshl_add_u32 v7, v31, 7, v5
    s_waitcnt vmcnt(9)
    v_mfma_f32_32x32x16_bf16 v[20:35], v[56:59], v[16:19], 0
    v_mfma_f32_32x32x16_bf16 v[76:91], v[52:55], v[16:19], v[36:51]
    s_waitcnt vmcnt(7)
    v_lshlrev_b32 v52, 16, v60
    v_and_b32 v53, 0xffff0000, v60
    v_lshlrev_b32 v54, 16, v61
    v_and_b32 v55, 0xffff0000, v61
    v_lshlrev_b32 v56, 16, v62
    v_and_b32 v57, 0xffff0000, v62
    v_lshlrev_b32 v58, 16, v63
    v_and_b32 v59, 0xffff0000, v63
    ds_write_b128 v7, v[52:55] offset:64
    ds_write_b128 v7, v[56:59] offset:80
    ds_read_b128 v[92:95], v5 offset:64
    ds_read_b128 v[96:99], v5 offset:80
    v_lshlrev_b32 v120, 16, v64
    v_and_b32 v121, 0xffff0000, v64
    v_lshlrev_b32 v122, 16, v65
    v_and_b32 v123, 0xffff0000, v65
    v_lshlrev_b32 v124, 16, v66
    v_and_b32 v125, 0xffff0000, v66
    v_lshlrev_b32 v126, 16, v67
    v_and_b32 v127, 0xffff0000, v67
    v_cvt_pk_bf16_f32 v16, v20, v21
    v_cvt_pk_bf16_f32 v17, v22, v23
    v_cvt_pk_bf16_f32 v18, v24, v25
    v_cvt_pk_bf16_f32 v19, v26, v27
    v_cvt_pk_bf16_f32 v64, -v28, -v29
    v_cvt_pk_bf16_f32 v65, -v30, -v31
    v_cvt_pk_bf16_f32 v66, -v32, -v33
    v_cvt_pk_bf16_f32 v67, -v34, -v35
    v_pk_add_f32 v[76:77], v[76:77], v[28:29]
    v_pk_add_f32 v[78:79], v[78:79], v[30:31]
    v_pk_add_f32 v[80:81], v[80:81], v[32:33]
    v_pk_add_f32 v[82:83], v[82:83], v[34:35]
    s_mov_b32 s64, 0xbfb8aa3b
    v_pk_mul_f32 v[76:77], v[76:77], s[64:65] op_sel_hi:[1,0]
    v_pk_mul_f32 v[78:79], v[78:79], s[64:65] op_sel_hi:[1,0]
    v_pk_mul_f32 v[80:81], v[80:81], s[64:65] op_sel_hi:[1,0]
    v_pk_mul_f32 v[82:83], v[82:83], s[64:65] op_sel_hi:[1,0]
    v_pk_mul_f32 v[84:85], v[84:85], s[64:65] op_sel_hi:[1,0]
    v_pk_mul_f32 v[86:87], v[86:87], s[64:65] op_sel_hi:[1,0]
    v_pk_mul_f32 v[88:89], v[88:89], s[64:65] op_sel_hi:[1,0]
    v_pk_mul_f32 v[90:91], v[90:91], s[64:65] op_sel_hi:[1,0]
    v_mfma_f32_32x32x16_bf16 v[20:35], v[16:19], v[60:63], v[120:135]
    v_mfma_f32_32x32x16_bf16 v[20:35], v[64:67], v[60:63], v[20:35]
    v_and_b32 v6, 8, v0
    v_bfe_u32 v4, v0, 5, 1
    v_lshl_add_u32 v6, v4, 2, v6
    v_bfe_u32 v4, v0, 2, 1
    v_lshl_add_u32 v6, v4, 1, v6
    v_bfe_u32 v4, v0, 4, 1
    v_add_lshl_u32 v6, v6, v4, 1
    v_mul_u32_u24 v4, 0x10020, v0
    v_and_b32 v4, 0x20020, v4
    v_or_b32 v6, v6, v4
    s_add_u32 s28, s18, s22
    s_addc_u32 s29, s19, 0
    s_mov_b32 s30, 393280
    v_mov_b64 v[68:69], 0
    v_mov_b64 v[70:71], 0
    v_mov_b64 v[72:73], 0
    v_mov_b64 v[74:75], 0
    s_waitcnt vmcnt(5) lgkmcnt(0)
    v_pk_mul_f32 v[20:21], v[20:21], s[64:65] op_sel_hi:[1,0]
    v_pk_mul_f32 v[22:23], v[22:23], s[64:65] op_sel_hi:[1,0]
    v_pk_mul_f32 v[24:25], v[24:25], s[64:65] op_sel_hi:[1,0]
    v_pk_mul_f32 v[26:27], v[26:27], s[64:65] op_sel_hi:[1,0]
    ds_write_b128 v7, v[20:23]
    ds_write_b128 v7, v[24:27] offset:16
    v_mov_b64 v[28:29], 0
    v_mov_b64 v[30:31], 0
    v_mov_b64 v[32:33], 0
    v_mov_b64 v[34:35], 0
    s_waitcnt lgkmcnt(0)
    ds_read_b128 v[20:23], v5
    ds_read_b128 v[24:27], v5 offset:16
    v_pk_fma_f32 v[92:93], v[92:93], v[84:85], v[76:77]
    v_pk_fma_f32 v[94:95], v[94:95], v[86:87], v[78:79]
    v_pk_fma_f32 v[96:97], v[96:97], v[88:89], v[80:81]
    v_pk_fma_f32 v[98:99], v[98:99], v[90:91], v[82:83]
    v_cvt_pk_bf16_f32 v16, v92, v93
    v_cvt_pk_bf16_f32 v17, v94, v95
    v_cvt_pk_bf16_f32 v18, v96, v97
    v_cvt_pk_bf16_f32 v19, v98, v99
    ds_read_b128 v[92:95], v5 offset:192
    ds_read_b128 v[96:99], v5 offset:208
    v_mov_b32 v13, v12
    v_mov_b32 v14, v12
    v_mov_b32 v15, v12
    s_mov_b32 s68, 0x11111111
    s_mov_b32 s69, 0x11111111
    s_mov_b32 s84, 0
    s_mov_b32 s85, 262144
    s_mov_b32 s80, 0
    s_mov_b32 s88, 1
    s_waitcnt lgkmcnt(0)
    v_mfma_f32_32x32x16_bf16 v[36:51], v[16:19], v[144:147], v[20:35]
    s_bitcmp1_b32 s2, 5
    s_cbranch_scc1 L_yp
    s_setprio 0
L_yp:
    s_branch L_over2
L_pad2:
    s_branch L_back
L_over2:
    s_nop 8
L_loop:
    v_exp_f32 v36, v36
    v_exp_f32 v37, v37
    v_exp_f32 v38, v38
    v_exp_f32 v39, v39
    v_exp_f32 v40, v40
    v_exp_f32 v41, v41
    v_exp_f32 v42, v42
    v_exp_f32 v43, v43
    s_bitcmp1_b64 s[66:67], s80
    v_pk_add_f32 v[36:37], v[36:37], 1.0 op_sel_hi:[1,0]
    v_pk_add_f32 v[38:39], v[38:39], 1.0 op_sel_hi:[1,0]
    v_pk_add_f32 v[40:41], v[40:41], 1.0 op_sel_hi:[1,0]
    v_pk_add_f32 v[42:43], v[42:43], 1.0 op_sel_hi:[1,0]
    v_rcp_f32 v36, v36
    v_rcp_f32 v37, v37
    v_rcp_f32 v38, v38
    v_rcp_f32 v39, v39
    v_rcp_f32 v40, v40
    v_rcp_f32 v41, v41
    v_rcp_f32 v42, v42
    v_rcp_f32 v43, v43
    s_waitcnt lgkmcnt(0)
    v_cvt_pk_bf16_f32 v36, v36, v37
    v_cvt_pk_bf16_f32 v37, v38, v39
    v_cvt_pk_bf16_f32 v38, v40, v41
    v_cvt_pk_bf16_f32 v39, v42, v43
    v_lshl_add_u32 v101, v100, 5, v1
    s_cbranch_scc1 L_new0
L_rnew0:
    v_mfma_f32_16x16x32_bf16 v[40:43], v[8:11], v[36:39], v[12:15]
    s_bitcmp1_b64 s[54:55], s80
    s_cselect_b32 s62, 26214400, 0
    s_add_u32 s24, s24, s62
    s_addc_u32 s25, s25, 0
    s_cmp_ge_i32 s80, s50
    s_waitcnt vmcnt(1)
    v_mfma_f32_32x32x16_bf16 v[52:67], v[16:19], v[140:143], v[20:35]
    buffer_load_dwordx4 v[140:143], v101, s[24:27], 0 offen nt
    s_cbranch_scc1 L_sbld0
L_rbld0:
    ds_read_u16 v100, v2 offset:512
    s_bitcmp1_b64 s[66:67], s80
    v_mul_f32 v40, v40, v102
    v_pk_fma_f32 v[68:69], v[44:45], v[40:41], v[68:69] op_sel_hi:[1,0,1]
    v_pk_fma_f32 v[70:71], v[46:47], v[40:41], v[70:71] op_sel_hi:[1,0,1]
    v_pk_fma_f32 v[72:73], v[48:49], v[40:41], v[72:73] op_sel_hi:[1,0,1]
    v_pk_fma_f32 v[74:75], v[50:51], v[40:41], v[74:75] op_sel_hi:[1,0,1]
    ds_read_u16_d16_hi v102, v2 offset:130
    s_cbranch_scc1 L_red0
L_rred0:
    s_add_u32 s80, s80, 1
    v_exp_f32 v52, v52
    v_exp_f32 v53, v53
    v_exp_f32 v54, v54
    v_exp_f32 v55, v55
    v_exp_f32 v56, v56
    v_exp_f32 v57, v57
    v_exp_f32 v58, v58
    v_exp_f32 v59, v59
    s_bitcmp1_b64 s[66:67], s80
    v_pk_add_f32 v[52:53], v[52:53], 1.0 op_sel_hi:[1,0]
    v_pk_add_f32 v[54:55], v[54:55], 1.0 op_sel_hi:[1,0]
    v_pk_add_f32 v[56:57], v[56:57], 1.0 op_sel_hi:[1,0]
    v_pk_add_f32 v[58:59], v[58:59], 1.0 op_sel_hi:[1,0]
    v_rcp_f32 v52, v52
    v_rcp_f32 v53, v53
    v_rcp_f32 v54, v54
    v_rcp_f32 v55, v55
    v_rcp_f32 v56, v56
    v_rcp_f32 v57, v57
    v_rcp_f32 v58, v58
    v_rcp_f32 v59, v59
    s_waitcnt lgkmcnt(0)
    v_cvt_pk_bf16_f32 v52, v52, v53
    v_cvt_pk_bf16_f32 v53, v54, v55
    v_cvt_pk_bf16_f32 v54, v56, v57
    v_cvt_pk_bf16_f32 v55, v58, v59
    v_lshl_add_u32 v101, v100, 5, v1
    s_cbranch_scc1 L_new1
L_rnew1:
    v_mfma_f32_16x16x32_bf16 v[56:59], v[8:11], v[52:55], v[12:15]
    s_bitcmp1_b64 s[54:55], s80
    s_cselect_b32 s62, 26214400, 0
    s_add_u32 s24, s24, s62
    s_addc_u32 s25, s25, 0
    s_cmp_ge_i32 s80, s50
    s_waitcnt vmcnt(1)
    v_mfma_f32_32x32x16_bf16 v[36:51], v[16:19], v[136:139], v[20:35]
    buffer_load_dwordx4 v[136:139], v101, s[24:27], 0 offen nt
    s_cbranch_scc1 L_sbld1
L_rbld1:
    ds_read_u16 v100, v2 offset:640
    s_bitcmp1_b64 s[66:67], s80
    v_mul_f32 v56, v56, v102
    v_pk_fma_f32 v[68:69], v[60:61], v[56:57], v[68:69] op_sel_hi:[1,0,1]
    v_pk_fma_f32 v[70:71], v[62:63], v[56:57], v[70:71] op_sel_hi:[1,0,1]
    v_pk_fma_f32 v[72:73], v[64:65], v[56:57], v[72:73] op_sel_hi:[1,0,1]
    v_pk_fma_f32 v[74:75], v[66:67], v[56:57], v[74:75] op_sel_hi:[1,0,1]
    ds_read_u16_d16_hi v102, v2 offset:258
    v_add_u32 v2, 256, v2
    s_cbranch_scc1 L_red1
L_rred1:
    s_add_u32 s80, s80, 1
    s_cmp_lt_u32 s80, 60
    s_cbranch_scc1 L_loop
    s_endpgm
L_pad3:
    s_branch L_back
L_sbld0:
    s_call_b64 s[70:71], L_bld
    s_branch L_rbld0
L_sbld1:
    s_call_b64 s[70:71], L_bld
    s_branch L_rbld1
L_new0:
    s_cmp_eq_u32 s88, 8
    s_cbranch_scc1 L_last0
    v_add_u32 v5, 128, v5
    ds_read_b128 v[20:23], v5
    ds_read_b128 v[24:27], v5 offset:16
    v_pk_fma_f32 v[92:93], v[92:93], v[84:85], v[76:77]
    v_pk_fma_f32 v[94:95], v[94:95], v[86:87], v[78:79]
    v_pk_fma_f32 v[96:97], v[96:97], v[88:89], v[80:81]
    v_pk_fma_f32 v[98:99], v[98:99], v[90:91], v[82:83]
    v_cvt_pk_bf16_f32 v16, v92, v93
    v_cvt_pk_bf16_f32 v17, v94, v95
    v_cvt_pk_bf16_f32 v18, v96, v97
    v_cvt_pk_bf16_f32 v19, v98, v99
    ds_read_b128 v[92:95], v5 offset:192
    ds_read_b128 v[96:99], v5 offset:208
    s_add_u32 s88, s88, 1
    s_waitcnt lgkmcnt(2)
    s_branch L_rnew0
L_red0:
    v_add_f32_dpp v68, v68, v68 row_ror:8 row_mask:0xf bank_mask:0xf
    v_add_f32_dpp v69, v69, v69 row_ror:8 row_mask:0xf bank_mask:0xf
    v_add_f32_dpp v70, v70, v70 row_ror:8 row_mask:0xf bank_mask:0xf
    v_add_f32_dpp v71, v71, v71 row_ror:8 row_mask:0xf bank_mask:0xf
    v_add_f32_dpp v68, v72, v72 row_ror:8 row_mask:0xf bank_mask:0xc
    v_add_f32_dpp v69, v73, v73 row_ror:8 row_mask:0xf bank_mask:0xc
    v_add_f32_dpp v70, v74, v74 row_ror:8 row_mask:0xf bank_mask:0xc
    v_add_f32_dpp v71, v75, v75 row_ror:8 row_mask:0xf bank_mask:0xc
    v_add_f32_dpp v68, v68, v68 row_half_mirror row_mask:0xf bank_mask:0xf
    v_add_f32_dpp v69, v69, v69 row_half_mirror row_mask:0xf bank_mask:0xf
    v_add_f32_dpp v68, v70, v70 row_half_mirror row_mask:0xf bank_mask:0xa
    v_add_f32_dpp v69, v71, v71 row_half_mirror row_mask:0xf bank_mask:0xa
    v_mov_b64 v[72:73], 0
    v_mov_b64 v[74:75], 0
    v_permlane16_swap_b32 v68, v69
    v_mov_b64 v[70:71], 0
    v_add_f32 v4, v68, v69
    v_mov_b64 v[68:69], 0
    s_add_u32 s84, s84, 1
    v_add_f32_dpp v4, v4, v4 quad_perm:[1,0,3,2] row_mask:0xf bank_mask:0xf
    s_nop 0
    s_cmp_eq_u32 s84, 4
    v_add_f32_dpp v4, v4, v4 quad_perm:[2,3,0,1] row_mask:0xf bank_mask:0xf
    v_cndmask_b32 v3, v3, v4, s[68:69]
    s_cbranch_scc1 L_four0
    s_lshl_b64 s[68:69], s[68:69], 1
    s_branch L_rred0
L_four0:
    v_mov_b32 v7, v3
    s_lshr_b64 s[68:69], s[68:69], 3
    s_branch L_rred0
L_new1:
    s_cmp_eq_u32 s88, 8
    s_cbranch_scc1 L_last1
    v_add_u32 v5, 128, v5
    ds_read_b128 v[20:23], v5
    ds_read_b128 v[24:27], v5 offset:16
    v_pk_fma_f32 v[92:93], v[92:93], v[84:85], v[76:77]
    v_pk_fma_f32 v[94:95], v[94:95], v[86:87], v[78:79]
    v_pk_fma_f32 v[96:97], v[96:97], v[88:89], v[80:81]
    v_pk_fma_f32 v[98:99], v[98:99], v[90:91], v[82:83]
    v_cvt_pk_bf16_f32 v16, v92, v93
    v_cvt_pk_bf16_f32 v17, v94, v95
    v_cvt_pk_bf16_f32 v18, v96, v97
    v_cvt_pk_bf16_f32 v19, v98, v99
    ds_read_b128 v[92:95], v5 offset:192
    ds_read_b128 v[96:99], v5 offset:208
    s_add_u32 s88, s88, 1
    s_waitcnt lgkmcnt(2)
    s_branch L_rnew1
L_red1:
    v_add_f32_dpp v68, v68, v68 row_ror:8 row_mask:0xf bank_mask:0xf
    v_add_f32_dpp v69, v69, v69 row_ror:8 row_mask:0xf bank_mask:0xf
    v_add_f32_dpp v70, v70, v70 row_ror:8 row_mask:0xf bank_mask:0xf
    v_add_f32_dpp v71, v71, v71 row_ror:8 row_mask:0xf bank_mask:0xf
    v_add_f32_dpp v68, v72, v72 row_ror:8 row_mask:0xf bank_mask:0xc
    v_add_f32_dpp v69, v73, v73 row_ror:8 row_mask:0xf bank_mask:0xc
    v_add_f32_dpp v70, v74, v74 row_ror:8 row_mask:0xf bank_mask:0xc
    v_add_f32_dpp v71, v75, v75 row_ror:8 row_mask:0xf bank_mask:0xc
    v_add_f32_dpp v68, v68, v68 row_half_mirror row_mask:0xf bank_mask:0xf
    v_add_f32_dpp v69, v69, v69 row_half_mirror row_mask:0xf bank_mask:0xf
    v_add_f32_dpp v68, v70, v70 row_half_mirror row_mask:0xf bank_mask:0xa
    v_add_f32_dpp v69, v71, v71 row_half_mirror row_mask:0xf bank_mask:0xa
    v_mov_b64 v[72:73], 0
    v_mov_b64 v[74:75], 0
    v_permlane16_swap_b32 v68, v69
    v_mov_b64 v[70:71], 0
    v_add_f32 v4, v68, v69
    v_mov_b64 v[68:69], 0
    s_add_u32 s84, s84, 1
    v_add_f32_dpp v4, v4, v4 quad_perm:[1,0,3,2] row_mask:0xf bank_mask:0xf
    s_nop 0
    s_cmp_eq_u32 s84, 4
    v_add_f32_dpp v4, v4, v4 quad_perm:[2,3,0,1] row_mask:0xf bank_mask:0xf
    v_cndmask_b32 v3, v3, v4, s[68:69]
    s_cbranch_scc1 L_four1
    s_lshl_b64 s[68:69], s[68:69], 1
    s_branch L_rred1
L_four1:
    v_mov_b32 v7, v3
    s_lshr_b64 s[68:69], s[68:69], 3
    s_branch L_rred1
L_last1:
    v_mfma_f32_16x16x32_bf16 v[56:59], v[8:11], v[52:55], v[12:15]
    s_nop 7
    v_mul_f32 v56, v56, v102
    v_pk_fma_f32 v[68:69], v[60:61], v[56:57], v[68:69] op_sel_hi:[1,0,1]
    v_pk_fma_f32 v[70:71], v[62:63], v[56:57], v[70:71] op_sel_hi:[1,0,1]
    v_pk_fma_f32 v[72:73], v[64:65], v[56:57], v[72:73] op_sel_hi:[1,0,1]
    v_pk_fma_f32 v[74:75], v[66:67], v[56:57], v[74:75] op_sel_hi:[1,0,1]
    s_branch L_fin
L_last0:
    v_mfma_f32_16x16x32_bf16 v[40:43], v[8:11], v[36:39], v[12:15]
    s_nop 7
    v_mul_f32 v40, v40, v102
    v_pk_fma_f32 v[68:69], v[44:45], v[40:41], v[68:69] op_sel_hi:[1,0,1]
    v_pk_fma_f32 v[70:71], v[46:47], v[40:41], v[70:71] op_sel_hi:[1,0,1]
    v_pk_fma_f32 v[72:73], v[48:49], v[40:41], v[72:73] op_sel_hi:[1,0,1]
    v_pk_fma_f32 v[74:75], v[50:51], v[40:41], v[74:75] op_sel_hi:[1,0,1]
    s_nop 0
L_fin:
    v_add_f32_dpp v68, v68, v68 row_ror:8 row_mask:0xf bank_mask:0xf
    v_add_f32_dpp v69, v69, v69 row_ror:8 row_mask:0xf bank_mask:0xf
    v_add_f32_dpp v70, v70, v70 row_ror:8 row_mask:0xf bank_mask:0xf
    v_add_f32_dpp v71, v71, v71 row_ror:8 row_mask:0xf bank_mask:0xf
    v_add_f32_dpp v68, v72, v72 row_ror:8 row_mask:0xf bank_mask:0xc
    v_add_f32_dpp v69, v73, v73 row_ror:8 row_mask:0xf bank_mask:0xc
    v_add_f32_dpp v70, v74, v74 row_ror:8 row_mask:0xf bank_mask:0xc
    v_add_f32_dpp v71, v75, v75 row_ror:8 row_mask:0xf bank_mask:0xc
    v_add_f32_dpp v68, v68, v68 row_half_mirror row_mask:0xf bank_mask:0xf
    v_add_f32_dpp v69, v69, v69 row_half_mirror row_mask:0xf bank_mask:0xf
    v_add_f32_dpp v68, v70, v70 row_half_mirror row_mask:0xf bank_mask:0xa
    v_add_f32_dpp v69, v71, v71 row_half_mirror row_mask:0xf bank_mask:0xa
    s_nop 1
    v_permlane16_swap_b32 v68, v69
    s_nop 0
    v_add_f32 v4, v68, v69
    s_nop 1
    v_add_f32_dpp v4, v4, v4 quad_perm:[1,0,3,2] row_mask:0xf bank_mask:0xf
    s_nop 1
    v_add_f32_dpp v4, v4, v4 quad_perm:[2,3,0,1] row_mask:0xf bank_mask:0xf
    v_cndmask_b32 v3, v3, v4, s[68:69]
    v_cvt_pk_bf16_f32 v7, v7, v3
    buffer_store_short v7, v6, s[28:31], 0 offen
    buffer_store_short_d16_hi v7, v6, s[28:31], s85 offen
L_end:
    s_endpgm
.section .rodata,"a"
.p2align 6
.amdhsa_kernel standalone__sequential_behavior_din__recsys_kernel
  .amdhsa_next_free_vgpr 256
  .amdhsa_next_free_sgpr 102
  .amdhsa_accum_offset 256
  .amdhsa_group_segment_fixed_size 0
  .amdhsa_kernarg_size 80
  .amdhsa_user_sgpr_count 2
  .amdhsa_user_sgpr_kernarg_segment_ptr 1
  .amdhsa_system_sgpr_workgroup_id_x 1
.end_amdhsa_kernel
```
